```python
import torch

def _softmax(x, axis=-1):
    return torch.softmax(x, dim=axis)
def _gelu(x):
    return torch.nn.functional.gelu(x, approximate="tanh")
def _silu(x):
    return torch.nn.functional.silu(x)
def _sigmoid(x):
    return torch.sigmoid(x)
def _layernorm(x, axis=-1, eps=1e-5):
    m = x.mean(dim=axis, keepdim=True)
    v = x.var(dim=axis, keepdim=True, unbiased=False)
    return (x - m) / torch.sqrt(v + eps)
def _scatter_add(tgt, idx, src, axis=0):
    return tgt.clone().index_add_(axis, idx, src)
def _segment_sum(src, seg, n):
    out = torch.zeros((n,) + src.shape[1:], dtype=src.dtype)
    return out.index_add_(0, seg, src)
def _pad(x, pw):
    flat = tuple(v for pair in reversed(pw) for v in pair)
    return torch.nn.functional.pad(x, flat)

kernel_name = 'standalone__sliding_block_cached__sampling'

def setup_inputs():

    _w = (lambda a: (lambda t: t.to(torch.bfloat16) if t.is_floating_point() else t)(torch.as_tensor(a)))
    B, Sq, D = 8, 8, 448
    Hq, Hkv, Sk, Dh = 16, 8, 8192, 256
    assert Hq % Hkv == 0, (Hq, Hkv)
    return {
        "x": _w((lambda *s: torch.randn(*s, dtype=torch.bfloat16) * 0.8)(B, Sq, D)),
        "k_cache": _w((lambda *s: torch.randn(*s, dtype=torch.bfloat16) * 0.8)(B, Hkv, Sk, Dh)),
        "v_cache": _w((lambda *s: torch.randn(*s, dtype=torch.bfloat16) * 0.05)(B, Hkv, Sk, Dh)),
        "wq": _w((lambda *s: torch.randn(*s, dtype=torch.bfloat16) * 0.8)(D, Hq * Dh) * (D ** -0.5)),
        "wo": _w((lambda *s: torch.randn(*s, dtype=torch.bfloat16) * 0.05)(Hq * Dh, D) * ((Hq * Dh) ** -0.5)),
    }

def reference(x, k_cache, v_cache, wq, wo):
    B, Sq, D = x.shape
    Hq, Dh = 16, 256
    Hkv, Sk = k_cache.shape[1], k_cache.shape[2]
    W = min(4096, max(256, Sk // 4))
    rep = Hq // Hkv
    q = (lambda x, *d: x.permute(*d))((x @ wq).reshape(B, Sq, Hq, Dh), 0, 2, 1, 3)
    k = (lambda x, n, axis: torch.repeat_interleave(x, n, dim=axis))(k_cache[:, :, Sk - W:, :], rep, axis=1)
    v = (lambda x, n, axis: torch.repeat_interleave(x, n, dim=axis))(v_cache[:, :, Sk - W:, :], rep, axis=1)
    scores = torch.einsum("bhqd,bhkd->bhqk", q, k) * (Dh ** -0.5)
    p = _softmax(scores, axis=-1)
    o = torch.einsum("bhqk,bhkd->bhqd", p, v)
    return (lambda x, *d: x.permute(*d))(o, 0, 2, 1, 3).reshape(B, Sq, Hq * Dh) @ wo
```

```asm
; @launch grid=(256,1,1) block=(512,1,1) lds=163840
.amdgcn_target "amdgcn-amd-amdhsa--gfx950"
.text
.globl standalone__sliding_block_cached__sampling_kernel
.p2align 8
.type standalone__sliding_block_cached__sampling_kernel,@function
standalone__sliding_block_cached__sampling_kernel:
    s_cmp_ge_u32 s2, 256
    s_cbranch_scc1 L_end
    s_load_dwordx16 s[4:19], s[0:1], 0
    s_getpc_b64 s[60:61]
L_pc:
    v_lshlrev_b32 v9, 5, v0
    v_min_u32 v9, L_end-L_pc, v9
    global_load_dword v8, v9, s[60:61]
    v_and_b32 v1, 63, v0
    v_lshrrev_b32 v10, 6, v0
    s_and_b32 s52, s2, 7
    s_lshr_b32 s54, s2, 3
    v_readfirstlane_b32 s55, v10
    s_and_b32 s53, s54, 3
    s_lshr_b32 s54, s54, 2
    v_bfe_u32 v10, v1, 1, 3
    v_lshrrev_b32 v11, 4, v1
    v_and_b32 v12, 1, v1
    v_lshlrev_b32 v2, 9, v10
    v_lshl_add_u32 v2, v11, 5, v2
    v_lshl_add_u32 v2, v12, 4, v2
    s_lshl_b32 s62, s54, 25
    s_lshl_b32 s63, s52, 22
    s_add_u32 s62, s62, s63
    s_add_u32 s62, s62, 0x300000
    s_lshl_b32 s63, s53, 18
    s_add_u32 s62, s62, s63
    s_mov_b32 s64, 0
    s_bitcmp1_b32 s2, 0
    s_cselect_b32 s63, 0x2b000, 0
    s_xor_b32 s64, s64, s63
    s_bitcmp1_b32 s2, 1
    s_cselect_b32 s63, 0x23000, 0
    s_xor_b32 s64, s64, s63
    s_bitcmp1_b32 s2, 2
    s_cselect_b32 s63, 0x1c000, 0
    s_xor_b32 s64, s64, s63
    s_bitcmp1_b32 s2, 3
    s_cselect_b32 s63, 0x6000, 0
    s_xor_b32 s64, s64, s63
    s_bitcmp1_b32 s2, 4
    s_cselect_b32 s63, 0x9000, 0
    s_xor_b32 s64, s64, s63
    s_bitcmp1_b32 s2, 5
    s_cselect_b32 s63, 0x2f000, 0
    s_xor_b32 s64, s64, s63
    s_bitcmp1_b32 s2, 6
    s_cselect_b32 s63, 0x14000, 0
    s_xor_b32 s64, s64, s63
    s_bitcmp1_b32 s2, 7
    s_cselect_b32 s63, 0x1a000, 0
    s_xor_b32 s64, s64, s63
    s_mov_b32 s65, s64
    s_bfe_u32 s63, s55, 0x10000
    s_lshl_b32 s63, s63, 12
    s_xor_b32 s65, s65, s63
    s_bfe_u32 s63, s55, 0x10001
    s_lshl_b32 s63, s63, 15
    s_xor_b32 s65, s65, s63
    s_bfe_u32 s63, s55, 0x10002
    s_lshl_b32 s63, s63, 13
    s_xor_b32 s65, s65, s63
    s_mov_b32 s22, 0x40000
    s_mov_b32 s23, 0x20000
    s_waitcnt lgkmcnt(0)
    s_add_u32 s20, s6, s62
    s_addc_u32 s21, s7, 0
    s_xor_b32 s66, s65, 0
    buffer_load_dwordx4 v[128:131], v2, s[20:23], s66 offen offset:0 nt
    buffer_load_dwordx4 v[132:135], v2, s[20:23], s66 offen offset:128 nt
    buffer_load_dwordx4 v[136:139], v2, s[20:23], s66 offen offset:256 nt
    s_lshr_b32 s63, s54, 1
    s_and_b32 s61, s54, 1
    s_lshl_b32 s61, s61, 2
    s_add_u32 s61, s61, s53
    s_lshl_b32 s60, s61, 2
    s_lshr_b32 s1, 0x37546210, s60
    s_and_b32 s1, s1, 7
    s_lshl_b32 s60, s52, 10
    s_lshl_b32 s71, s1, 7
    s_add_u32 s60, s60, s71
    s_add_u32 s28, s10, s60
    s_addc_u32 s29, s11, 0
    s_sub_u32 s30, 3670016, s60
    s_mov_b32 s31, 0x20000
    v_and_b32 v13, 7, v1
    v_bfe_u32 v14, v1, 4, 1
    v_lshlrev_b32 v14, 1, v14
    v_xor_b32 v13, v13, v14
    v_lshlrev_b32 v13, 4, v13
    v_lshrrev_b32 v14, 3, v1
    v_lshl_add_u32 v120, v14, 13, v13
    s_and_b32 s60, s55, 1
    s_lshl_b32 s60, s60, 6
    v_xor_b32 v120, s60, v120
    v_xor_b32 v121, 64, v120
    s_mul_i32 s67, s55, 458752
    s_mul_i32 s69, s55, 7168
    s_mul_i32 s60, s63, 14336
    s_add_u32 s32, s4, s60
    s_addc_u32 s33, s5, 0
    s_mov_b32 s34, 14336
    s_mov_b32 s35, 0x20000
    v_lshlrev_b32 v4, 4, v1
    s_lshl_b32 s60, s55, 11
    s_add_u32 s71, s60, 147456
    s_cmp_eq_u32 s55, 7
    s_cselect_b32 m0, 73728, s71
    s_nop 0
    buffer_load_dwordx4 v4, s[32:35], s60 offen offset:0  lds
    s_lshl_b32 s60, s55, 11
    s_add_u32 s71, s60, 147456
    s_cmp_eq_u32 s55, 7
    s_cselect_b32 m0, 73728, s71
    s_nop 0
    buffer_load_dwordx4 v4, s[32:35], s60 offen offset:1024  lds
    s_lshl_b32 s60, s63, 22
    s_add_u32 s44, s18, s60
    s_addc_u32 s45, s19, 0
    s_mov_b32 s46, 0x400000
    s_mov_b32 s47, 0x20000
    s_load_dword s56, s[44:45], 0
    s_add_u32 s24, s8, s62
    s_addc_u32 s25, s9, 0
    s_mov_b32 s26, 0x40000
    s_mov_b32 s27, 0x20000
    s_lshl_b32 s60, s54, 21
    s_add_u32 s40, s18, s60
    s_addc_u32 s41, s19, 0
    s_mov_b32 s42, 0x200000
    s_mov_b32 s43, 0x20000
    s_lshl_b32 s60, s52, 9
    s_and_b32 s71, s53, 1
    s_lshl_b32 s71, s71, 7
    s_add_u32 s60, s60, s71
    s_mul_i32 s60, s60, 896
    s_add_u32 s36, s12, s60
    s_addc_u32 s37, s13, 0
    s_sub_u32 s38, 3670016, s60
    s_mov_b32 s39, 0x20000
    s_mov_b32 s48, s14
    s_mov_b32 s49, s15
    s_mov_b32 s50, 57344
    s_mov_b32 s51, 0x20000
    s_mov_b32 s57, 0x3db8aa3b
    s_mov_b32 s58, 0x05040100
    s_mov_b32 s59, 0x07060302
    s_lshr_b32 s9, s55, 2
    v_xor_b32 v10, s9, v10
    v_lshlrev_b32 v3, 4, v10
    v_lshl_add_u32 v3, v11, 10, v3
    v_lshl_add_u32 v3, v12, 9, v3
    s_lshl_b32 s68, s9, 13
    s_xor_b32 s68, s68, s64
    s_and_b32 s10, s55, 3
    s_lshl_b32 s71, s10, 7
    s_or_b32 s68, s68, s71
    v_bfe_u32 v7, v1, 2, 2
    v_lshl_add_u32 v7, v11, 3, v7
    v_lshlrev_b32 v7, 7, v7
    v_bfe_u32 v15, v1, 3, 2
    v_lshl_add_u32 v7, v15, 5, v7
    v_and_b32 v15, 3, v1
    v_lshl_add_u32 v7, v15, 3, v7
    v_mul_u32_u24 v14, 896, v14
    v_add_u32 v5, v14, v13
    v_xor_b32 v13, 64, v13
    v_add_u32 v6, v14, v13
    s_lshl_b32 s4, s55, 13
    s_add_u32 s4, s4, 8192
    s_and_b32 s5, s54, 1
    s_and_b32 s60, s61, 6
    s_add_u32 s60, s60, s9
    s_bfe_u32 s6, s55, 0x10001
    s_lshl_b32 s6, s6, 2
    s_and_b32 s71, s55, 1
    s_add_u32 s6, s6, s71
    s_mul_i32 s6, s6, 57344
    s_lshl_b32 s71, s60, 7
    s_add_u32 s6, s6, s71
    s_cmp_eq_u32 s60, 7
    s_cselect_b32 s6, 0x40000000, s6
    s_lshl_b32 s11, s52, 2
    s_add_u32 s11, s11, s53
    s_mov_b32 s3, 0x40000
    s_getreg_b32 s16, hwreg(HW_REG_XCC_ID)
    s_and_b32 s16, s16, 15
    s_cmp_eq_u32 s1, 3
    s_cselect_b32 s101, 1, 0
    s_bfe_u32 s60, s16, 0x10000
    s_lshl_b32 s60, s60, 1
    s_or_b32 s101, s101, s60
    s_and_b32 s60, s55, 4
    s_cmp_eq_u32 s60, 4
    s_cselect_b32 s60, 4, 0
    s_or_b32 s101, s101, s60
    s_mov_b32 s70, s16
    v_mov_b32 v122, 0
    v_lshlrev_b32 v15, 2, v1
    v_add_u32 v15, 161792, v15
    ds_write_b32 v15, v122
    s_waitcnt lgkmcnt(0)
    s_barrier
    s_add_u32 s56, s56, 1
    s_lshl_b32 s60, s52, 7
    s_lshl_b32 s71, s61, 4
    s_add_u32 s60, s60, s71
    s_add_u32 s60, s60, 24576
    s_cmp_eq_u32 s55, 7
    s_cselect_b32 s60, s60, 0x40000000
    v_mov_b32 v124, s16
    v_mov_b32 v125, s56
    s_mov_b64 exec, 1
    buffer_store_dwordx2 v[124:125], v122, s[44:47], s60 offen sc1
    s_mov_b64 exec, -1
    s_lshl_b32 s14, s52, 2
    s_add_u32 s14, s14, s10
    s_lshl_b32 s14, s14, 2
    s_add_u32 s14, s14, s53
    s_lshl_b32 s14, s14, 1
    s_add_u32 s14, s14, s9
    s_lshl_b32 s14, s14, 10
    s_add_u32 s14, s14, 819200
    s_waitcnt vmcnt(5)
    buffer_load_dwordx4 v[140:143], v2, s[20:23], s66 offen offset:384 nt
    s_add_u32 m0, s69, 90112
    s_add_u32 s60, s67, 0
    buffer_load_dwordx4 v120, s[28:31], s60 offen nt lds
    s_waitcnt vmcnt(6)
    s_xor_b32 s66, s65, 16384
    buffer_load_dwordx4 v[144:147], v2, s[20:23], s66 offen offset:0 nt
    s_add_u32 m0, s69, 91136
    s_add_u32 s60, s67, 65536
    buffer_load_dwordx4 v121, s[28:31], s60 offen nt lds
    s_waitcnt vmcnt(7)
    buffer_load_dwordx4 v[148:151], v2, s[20:23], s66 offen offset:128 nt
    s_add_u32 m0, s69, 92160
    s_add_u32 s60, s67, 131072
    buffer_load_dwordx4 v120, s[28:31], s60 offen nt lds
    s_waitcnt vmcnt(5)
    buffer_load_dwordx4 v[152:155], v2, s[20:23], s66 offen offset:256 nt
    s_add_u32 m0, s69, 93184
    s_add_u32 s60, s67, 196608
    buffer_load_dwordx4 v121, s[28:31], s60 offen nt lds
    s_waitcnt vmcnt(5)
    buffer_load_dwordx4 v[156:159], v2, s[20:23], s66 offen offset:384 nt
    s_add_u32 m0, s69, 94208
    s_add_u32 s60, s67, 262144
    buffer_load_dwordx4 v120, s[28:31], s60 offen nt lds
    s_waitcnt vmcnt(5)
    s_xor_b32 s66, s65, 131072
    buffer_load_dwordx4 v[160:163], v2, s[20:23], s66 offen offset:0 nt
    s_add_u32 m0, s69, 95232
    s_add_u32 s60, s67, 327680
    buffer_load_dwordx4 v121, s[28:31], s60 offen nt lds
    s_waitcnt vmcnt(5)
    buffer_load_dwordx4 v[164:167], v2, s[20:23], s66 offen offset:128 nt
    s_add_u32 m0, s69, 96256
    s_add_u32 s60, s67, 393216
    buffer_load_dwordx4 v120, s[28:31], s60 offen nt lds
    v_and_b32 v126, 0x70, v4
    s_lshl_b32 s60, s52, 7
    s_add_u32 s60, s60, 24576
    buffer_load_dwordx2 v[124:125], v126, s[44:47], s60 offen sc1
    s_waitcnt vmcnt(8)
    s_and_b32 s60, s101, 1
    s_cbranch_scc1 L_bo10
    s_waitcnt vmcnt(6)
L_bo10:
    buffer_load_dwordx4 v[168:171], v2, s[20:23], s66 offen offset:256 nt
    s_waitcnt vmcnt(7)
    s_and_b32 s60, s101, 1
    s_cbranch_scc1 L_bo11
    s_waitcnt vmcnt(5)
L_bo11:
    buffer_load_dwordx4 v[172:175], v2, s[20:23], s66 offen offset:384 nt
    s_waitcnt vmcnt(6)
    s_and_b32 s60, s101, 1
    s_cbranch_scc1 L_bo12
    s_waitcnt vmcnt(4)
L_bo12:
    s_xor_b32 s66, s65, 147456
    buffer_load_dwordx4 v[176:179], v2, s[20:23], s66 offen offset:0 nt
    s_waitcnt vmcnt(5)
    s_and_b32 s60, s101, 1
    s_cbranch_scc1 L_bo13
    s_waitcnt vmcnt(2)
L_bo13:
    buffer_load_dwordx4 v[180:183], v2, s[20:23], s66 offen offset:128 nt
    s_waitcnt vmcnt(4)
    v_cmp_ne_u32 vcc, s70, v124
    v_cmp_ne_u32 s[12:13], s56, v125
    s_nop 0
    s_or_b64 vcc, vcc, s[12:13]
    s_cselect_b32 s16, 0, 1
    s_waitcnt vmcnt(3)
    s_and_b32 s60, s101, 1
    s_cbranch_scc1 L_bo14
    s_waitcnt vmcnt(2)
L_bo14:
    buffer_load_dwordx4 v[184:187], v2, s[20:23], s66 offen offset:256 nt
    s_waitcnt vmcnt(6)
    v_mov_b32 v14, 161792
    v_mov_b32 v9, 1
    s_mov_b64 exec, 1
    ds_add_u32 v14, v9
    s_mov_b64 exec, -1
    s_waitcnt vmcnt(3)
    s_and_b32 s60, s101, 1
    s_cbranch_scc1 L_bo15
    s_waitcnt vmcnt(2)
L_bo15:
    buffer_load_dwordx4 v[188:191], v2, s[20:23], s66 offen offset:384 nt
    s_mov_b32 s17, 0x40000000
    s_cmp_ge_u32 s55, 4
    s_cbranch_scc1 L_noq
    s_lshl_b32 s60, s55, 5
    v_xor_b32 v12, s60, v7
    v_add_u32 v12, 90112, v12
    v_and_b32 v13, 15, v1
    v_mul_u32_u24 v13, 896, v13
    v_lshrrev_b32 v14, 4, v1
    v_lshl_add_u32 v13, v14, 4, v13
    v_add_u32 v13, 147456, v13
L_aw0:
    s_sub_u32 s3, s3, 1
    s_cbranch_scc1 L_fin
    v_mov_b32 v9, 161792
    ds_read_b32 v9, v9
    ds_read_b64_tr_b16 v[16:17], v12 offset:0
    ds_read_b64_tr_b16 v[18:19], v12 offset:512
    ds_read_b128 v[20:23], v13 offset:0
    ds_read_b64_tr_b16 v[24:25], v12 offset:4096
    ds_read_b64_tr_b16 v[26:27], v12 offset:4608
    ds_read_b128 v[28:31], v13 offset:64
    ds_read_b64_tr_b16 v[32:33], v12 offset:8192
    ds_read_b64_tr_b16 v[34:35], v12 offset:8704
    ds_read_b128 v[36:39], v13 offset:128
    ds_read_b64_tr_b16 v[40:41], v12 offset:12288
    ds_read_b64_tr_b16 v[42:43], v12 offset:12800
    ds_read_b128 v[44:47], v13 offset:192
    ds_read_b64_tr_b16 v[48:49], v12 offset:16384
    ds_read_b64_tr_b16 v[50:51], v12 offset:16896
    ds_read_b128 v[52:55], v13 offset:256
    ds_read_b64_tr_b16 v[56:57], v12 offset:20480
    ds_read_b64_tr_b16 v[58:59], v12 offset:20992
    ds_read_b128 v[60:63], v13 offset:320
    ds_read_b64_tr_b16 v[64:65], v12 offset:24576
    ds_read_b64_tr_b16 v[66:67], v12 offset:25088
    ds_read_b128 v[68:71], v13 offset:384
    ds_read_b64_tr_b16 v[72:73], v12 offset:28672
    ds_read_b64_tr_b16 v[74:75], v12 offset:29184
    ds_read_b128 v[76:79], v13 offset:448
    ds_read_b64_tr_b16 v[80:81], v12 offset:32768
    ds_read_b64_tr_b16 v[82:83], v12 offset:33280
    ds_read_b128 v[84:87], v13 offset:512
    ds_read_b64_tr_b16 v[88:89], v12 offset:36864
    ds_read_b64_tr_b16 v[90:91], v12 offset:37376
    ds_read_b128 v[92:95], v13 offset:576
    ds_read_b64_tr_b16 v[96:97], v12 offset:40960
    ds_read_b64_tr_b16 v[98:99], v12 offset:41472
    ds_read_b128 v[100:103], v13 offset:640
    ds_read_b64_tr_b16 v[104:105], v12 offset:45056
    ds_read_b64_tr_b16 v[106:107], v12 offset:45568
    ds_read_b128 v[108:111], v13 offset:704
    ds_read_b64_tr_b16 v[112:113], v12 offset:49152
    ds_read_b64_tr_b16 v[114:115], v12 offset:49664
    ds_read_b128 v[116:119], v13 offset:768
    ds_read_b64_tr_b16 v[120:121], v12 offset:53248
    ds_read_b64_tr_b16 v[122:123], v12 offset:53760
    ds_read_b128 v[124:127], v13 offset:832
    s_waitcnt lgkmcnt(0)
    v_readfirstlane_b32 s60, v9
    s_nop 0
    s_cmp_lt_u32 s60, 8
    s_cbranch_scc1 L_aw0
    v_mfma_f32_16x16x32_bf16 v[8:11], v[16:19], v[20:23], 0
    v_mfma_f32_16x16x32_bf16 v[8:11], v[24:27], v[28:31], v[8:11]
    v_mfma_f32_16x16x32_bf16 v[8:11], v[32:35], v[36:39], v[8:11]
    v_mfma_f32_16x16x32_bf16 v[8:11], v[40:43], v[44:47], v[8:11]
    v_mfma_f32_16x16x32_bf16 v[8:11], v[48:51], v[52:55], v[8:11]
    v_mfma_f32_16x16x32_bf16 v[8:11], v[56:59], v[60:63], v[8:11]
    v_mfma_f32_16x16x32_bf16 v[8:11], v[64:67], v[68:71], v[8:11]
    v_mfma_f32_16x16x32_bf16 v[8:11], v[72:75], v[76:79], v[8:11]
    v_mfma_f32_16x16x32_bf16 v[8:11], v[80:83], v[84:87], v[8:11]
    v_mfma_f32_16x16x32_bf16 v[8:11], v[88:91], v[92:95], v[8:11]
    v_mfma_f32_16x16x32_bf16 v[8:11], v[96:99], v[100:103], v[8:11]
    v_mfma_f32_16x16x32_bf16 v[8:11], v[104:107], v[108:111], v[8:11]
    v_mfma_f32_16x16x32_bf16 v[8:11], v[112:115], v[116:119], v[8:11]
    v_mfma_f32_16x16x32_bf16 v[8:11], v[120:123], v[124:127], v[8:11]
    v_bfe_u32 v12, v1, 3, 1
    v_lshlrev_b32 v12, 11, v12
    v_lshl_add_u32 v12, v14, 7, v12
    v_and_b32 v13, 7, v1
    v_lshl_add_u32 v12, v13, 4, v12
    s_lshl_b32 s60, s52, 3
    s_add_u32 s60, s60, s1
    s_lshl_b32 s60, s60, 12
    s_lshl_b32 s71, s55, 9
    s_add_u32 s60, s60, s71
    s_add_u32 s17, s60, 32768
    v_mov_b32 v19, s56
    v_mov_b32 v18, 0
    v_cvt_pk_bf16_f32 v16, v8, v9
    v_cvt_pk_bf16_f32 v17, v10, v11
L_noq:
    s_cmp_eq_u32 s16, 1
    s_cbranch_scc0 L_far0
    buffer_store_dwordx4 v[16:19], v12, s[44:47], s17 offen
L_near0:
    s_waitcnt vmcnt(4)
    s_and_b32 s60, s101, 1
    s_cbranch_scc1 L_bo16
    s_waitcnt vmcnt(3)
L_bo16:
    s_xor_b32 s66, s65, 65536
    buffer_load_dwordx4 v[192:195], v2, s[20:23], s66 offen offset:0 nt
    s_waitcnt vmcnt(4)
    s_and_b32 s60, s101, 1
    s_cbranch_scc1 L_bo17
    s_waitcnt vmcnt(3)
L_bo17:
    buffer_load_dwordx4 v[196:199], v2, s[20:23], s66 offen offset:128 nt
    s_waitcnt vmcnt(4)
    s_and_b32 s60, s101, 1
    s_cbranch_scc1 L_bo18
    s_waitcnt vmcnt(3)
L_bo18:
    buffer_load_dwordx4 v[200:203], v2, s[20:23], s66 offen offset:256 nt
    s_waitcnt vmcnt(4)
    s_and_b32 s60, s101, 1
    s_cbranch_scc1 L_bo19
    s_waitcnt vmcnt(2)
L_bo19:
    buffer_load_dwordx4 v[204:207], v2, s[20:23], s66 offen offset:384 nt
    s_waitcnt vmcnt(3)
    s_and_b32 s60, s101, 1
    s_cbranch_scc1 L_bo20
    s_waitcnt vmcnt(2)
L_bo20:
    s_xor_b32 s66, s65, 81920
    buffer_load_dwordx4 v[208:211], v2, s[20:23], s66 offen offset:0 nt
    s_waitcnt vmcnt(3)
    s_and_b32 s60, s101, 1
    s_cbranch_scc1 L_bo21
    s_waitcnt vmcnt(2)
L_bo21:
    buffer_load_dwordx4 v[212:215], v2, s[20:23], s66 offen offset:128 nt
    s_waitcnt vmcnt(3)
    s_and_b32 s60, s101, 1
    s_cbranch_scc1 L_bo22
    s_waitcnt vmcnt(2)
L_bo22:
    buffer_load_dwordx4 v[216:219], v2, s[20:23], s66 offen offset:256 nt
    s_waitcnt vmcnt(3)
    s_and_b32 s60, s101, 1
    s_cbranch_scc1 L_bo23
    s_waitcnt vmcnt(2)
L_bo23:
    buffer_load_dwordx4 v[220:223], v2, s[20:23], s66 offen offset:384 nt
    s_lshl_b32 s60, s52, 3
    s_add_u32 s60, s60, s55
    s_lshl_b32 s60, s60, 12
    s_and_b32 s71, s54, 1
    s_lshl_b32 s71, s71, 11
    s_add_u32 s60, s60, s71
    s_add_u32 s60, s60, 32768
    buffer_load_dwordx4 v[16:19], v4, s[44:47], s60 offen sc1
    buffer_load_dwordx4 v[20:23], v4, s[44:47], s60 offen offset:1024 sc1
    s_waitcnt vmcnt(5)
    s_and_b32 s60, s101, 1
    s_cbranch_scc1 L_bo24
    s_waitcnt vmcnt(4)
L_bo24:
    s_xor_b32 s66, s65, 196608
    buffer_load_dwordx4 v[224:227], v2, s[20:23], s66 offen offset:0 nt
    s_waitcnt vmcnt(5)
    s_and_b32 s60, s101, 1
    s_cbranch_scc1 L_bo25
    s_waitcnt vmcnt(4)
L_bo25:
    buffer_load_dwordx4 v[228:231], v2, s[20:23], s66 offen offset:128 nt
    s_waitcnt vmcnt(5)
    s_and_b32 s60, s101, 1
    s_cbranch_scc1 L_bo26
    s_waitcnt vmcnt(4)
L_bo26:
    buffer_load_dwordx4 v[232:235], v2, s[20:23], s66 offen offset:256 nt
    v_bfe_u32 v12, v1, 4, 1
    v_lshlrev_b32 v12, 10, v12
    v_lshrrev_b32 v13, 5, v1
    v_lshl_add_u32 v12, v13, 8, v12
    v_and_b32 v13, 7, v1
    v_lshl_add_u32 v12, v13, 4, v12
    v_and_b32 v13, 8, v1
    v_add_u32 v12, v12, v13
    s_lshl_b32 s60, s10, 11
    s_lshl_b32 s71, s9, 7
    s_add_u32 s60, s60, s71
    s_add_u32 s60, s60, 0
    v_add_u32 v12, s60, v12
    s_waitcnt vmcnt(3)
L_chk_q:
    v_cmpx_eq_u32 vcc, s56, v19
    v_cmpx_eq_u32 vcc, s56, v23
    s_nop 0
    s_cmp_eq_u64 exec, -1
    s_mov_b64 exec, -1
    s_cbranch_scc0 L_retry_q
    ds_write_b64 v12, v[16:17]
    ds_write_b64 v12, v[20:21] offset:512
    v_mov_b32 v14, 161796
    v_mov_b32 v9, 1
    s_mov_b64 exec, 1
    ds_add_u32 v14, v9
    s_mov_b64 exec, -1
    s_waitcnt vmcnt(5)
    s_and_b32 s60, s101, 1
    s_cbranch_scc1 L_bo27
    s_waitcnt vmcnt(2)
L_bo27:
    buffer_load_dwordx4 v[236:239], v2, s[20:23], s66 offen offset:384 nt
    s_waitcnt vmcnt(3)
    s_and_b32 s60, s101, 1
    s_cbranch_scc1 L_bo28
    s_waitcnt vmcnt(2)
L_bo28:
    s_xor_b32 s66, s65, 212992
    buffer_load_dwordx4 v[240:243], v2, s[20:23], s66 offen offset:0 nt
L_aw1:
    s_sub_u32 s3, s3, 1
    s_cbranch_scc1 L_fin
    v_mov_b32 v9, 161796
    ds_read_b32 v9, v9
    ds_read_b128 v[96:99], v4 offset:0
    ds_read_b128 v[100:103], v4 offset:1024
    ds_read_b128 v[104:107], v4 offset:2048
    ds_read_b128 v[108:111], v4 offset:3072
    ds_read_b128 v[112:115], v4 offset:4096
    ds_read_b128 v[116:119], v4 offset:5120
    ds_read_b128 v[120:123], v4 offset:6144
    ds_read_b128 v[124:127], v4 offset:7168
    s_waitcnt lgkmcnt(0)
    v_readfirstlane_b32 s60, v9
    s_nop 0
    s_cmp_lt_u32 s60, 8
    s_cbranch_scc1 L_aw1
    s_waitcnt vmcnt(36)
    v_mfma_f32_16x16x32_bf16 v[64:67], v[128:131], v[96:99], 0
    v_mfma_f32_16x16x32_bf16 v[68:71], v[128:131], v[100:103], 0
    v_mfma_f32_16x16x32_bf16 v[64:67], v[132:135], v[104:107], v[64:67]
    v_mfma_f32_16x16x32_bf16 v[68:71], v[132:135], v[108:111], v[68:71]
    v_mfma_f32_16x16x32_bf16 v[64:67], v[136:139], v[112:115], v[64:67]
    v_mfma_f32_16x16x32_bf16 v[68:71], v[136:139], v[116:119], v[68:71]
    v_mfma_f32_16x16x32_bf16 v[64:67], v[140:143], v[120:123], v[64:67]
    v_mfma_f32_16x16x32_bf16 v[68:71], v[140:143], v[124:127], v[68:71]
    s_waitcnt vmcnt(3)
    s_and_b32 s60, s101, 1
    s_cbranch_scc1 L_bo29
    s_waitcnt vmcnt(2)
L_bo29:
    buffer_load_dwordx4 v[244:247], v2, s[20:23], s66 offen offset:128 nt
    s_waitcnt vmcnt(29)
    v_mfma_f32_16x16x32_bf16 v[72:75], v[144:147], v[96:99], 0
    v_mfma_f32_16x16x32_bf16 v[76:79], v[144:147], v[100:103], 0
    v_mfma_f32_16x16x32_bf16 v[72:75], v[148:151], v[104:107], v[72:75]
    v_mfma_f32_16x16x32_bf16 v[76:79], v[148:151], v[108:111], v[76:79]
    v_mfma_f32_16x16x32_bf16 v[72:75], v[152:155], v[112:115], v[72:75]
    v_mfma_f32_16x16x32_bf16 v[76:79], v[152:155], v[116:119], v[76:79]
    v_mfma_f32_16x16x32_bf16 v[72:75], v[156:159], v[120:123], v[72:75]
    v_mfma_f32_16x16x32_bf16 v[76:79], v[156:159], v[124:127], v[76:79]
    v_add_f32 v80, v64, v69
    v_add_f32 v88, v66, v71
    v_cvt_pk_bf16_f32 v88, v80, v88
    v_lshlrev_b32 v80, 16, v88
    v_and_b32 v88, 0xffff0000, v88
    v_max_f32 v15, v80, v88
    s_waitcnt vmcnt(3)
    s_and_b32 s60, s101, 1
    s_cbranch_scc1 L_bo30
    s_waitcnt vmcnt(2)
L_bo30:
    buffer_load_dwordx4 v[248:251], v2, s[20:23], s66 offen offset:256 nt
    s_waitcnt vmcnt(22)
    v_mfma_f32_16x16x32_bf16 v[64:67], v[160:163], v[96:99], 0
    v_mfma_f32_16x16x32_bf16 v[68:71], v[160:163], v[100:103], 0
    v_mfma_f32_16x16x32_bf16 v[64:67], v[164:167], v[104:107], v[64:67]
    v_mfma_f32_16x16x32_bf16 v[68:71], v[164:167], v[108:111], v[68:71]
    v_mfma_f32_16x16x32_bf16 v[64:67], v[168:171], v[112:115], v[64:67]
    v_mfma_f32_16x16x32_bf16 v[68:71], v[168:171], v[116:119], v[68:71]
    v_mfma_f32_16x16x32_bf16 v[64:67], v[172:175], v[120:123], v[64:67]
    v_mfma_f32_16x16x32_bf16 v[68:71], v[172:175], v[124:127], v[68:71]
    v_add_f32 v81, v72, v77
    v_add_f32 v89, v74, v79
    v_cvt_pk_bf16_f32 v89, v81, v89
    v_lshlrev_b32 v81, 16, v89
    v_and_b32 v89, 0xffff0000, v89
    v_max3_f32 v15, v15, v81, v89
    s_waitcnt vmcnt(3)
    s_and_b32 s60, s101, 1
    s_cbranch_scc1 L_bo31
    s_waitcnt vmcnt(2)
L_bo31:
    buffer_load_dwordx4 v[252:255], v2, s[20:23], s66 offen offset:384 nt
    v_mov_b32 v24, -1
    v_mov_b32 v25, -1
    v_mov_b32 v26, -1
    v_mov_b32 v27, -1
    s_cmp_eq_u32 s16, 1
    s_cbranch_scc0 L_far1
    buffer_store_dwordx4 v[24:27], v4, s[40:43], s14 offen
L_near1:
    s_waitcnt vmcnt(20)
    v_mfma_f32_16x16x32_bf16 v[72:75], v[176:179], v[96:99], 0
    v_mfma_f32_16x16x32_bf16 v[76:79], v[176:179], v[100:103], 0
    v_mfma_f32_16x16x32_bf16 v[72:75], v[180:183], v[104:107], v[72:75]
    v_mfma_f32_16x16x32_bf16 v[76:79], v[180:183], v[108:111], v[76:79]
    v_mfma_f32_16x16x32_bf16 v[72:75], v[184:187], v[112:115], v[72:75]
    v_mfma_f32_16x16x32_bf16 v[76:79], v[184:187], v[116:119], v[76:79]
    v_mfma_f32_16x16x32_bf16 v[72:75], v[188:191], v[120:123], v[72:75]
    v_mfma_f32_16x16x32_bf16 v[76:79], v[188:191], v[124:127], v[76:79]
    v_add_f32 v82, v64, v69
    v_add_f32 v90, v66, v71
    v_cvt_pk_bf16_f32 v90, v82, v90
    v_lshlrev_b32 v82, 16, v90
    v_and_b32 v90, 0xffff0000, v90
    v_max3_f32 v15, v15, v82, v90
    s_waitcnt vmcnt(4)
    s_and_b32 s60, s101, 1
    s_cbranch_scc1 L_bo32
    s_waitcnt vmcnt(3)
L_bo32:
    s_xor_b32 s66, s68, 0
    buffer_load_dwordx4 v[128:131], v3, s[24:27], s66 offen nt
    s_waitcnt vmcnt(16)
    v_mfma_f32_16x16x32_bf16 v[64:67], v[192:195], v[96:99], 0
    v_mfma_f32_16x16x32_bf16 v[68:71], v[192:195], v[100:103], 0
    v_mfma_f32_16x16x32_bf16 v[64:67], v[196:199], v[104:107], v[64:67]
    v_mfma_f32_16x16x32_bf16 v[68:71], v[196:199], v[108:111], v[68:71]
    v_mfma_f32_16x16x32_bf16 v[64:67], v[200:203], v[112:115], v[64:67]
    v_mfma_f32_16x16x32_bf16 v[68:71], v[200:203], v[116:119], v[68:71]
    v_mfma_f32_16x16x32_bf16 v[64:67], v[204:207], v[120:123], v[64:67]
    v_mfma_f32_16x16x32_bf16 v[68:71], v[204:207], v[124:127], v[68:71]
    v_add_f32 v83, v72, v77
    v_add_f32 v91, v74, v79
    v_cvt_pk_bf16_f32 v91, v83, v91
    v_lshlrev_b32 v83, 16, v91
    v_and_b32 v91, 0xffff0000, v91
    v_max3_f32 v15, v15, v83, v91
    s_waitcnt vmcnt(4)
    s_and_b32 s60, s101, 1
    s_cbranch_scc1 L_bo33
    s_waitcnt vmcnt(3)
L_bo33:
    s_xor_b32 s66, s68, 16384
    buffer_load_dwordx4 v[132:135], v3, s[24:27], s66 offen nt
    s_waitcnt vmcnt(13)
    v_mfma_f32_16x16x32_bf16 v[72:75], v[208:211], v[96:99], 0
    v_mfma_f32_16x16x32_bf16 v[76:79], v[208:211], v[100:103], 0
    v_mfma_f32_16x16x32_bf16 v[72:75], v[212:215], v[104:107], v[72:75]
    v_mfma_f32_16x16x32_bf16 v[76:79], v[212:215], v[108:111], v[76:79]
    v_mfma_f32_16x16x32_bf16 v[72:75], v[216:219], v[112:115], v[72:75]
    v_mfma_f32_16x16x32_bf16 v[76:79], v[216:219], v[116:119], v[76:79]
    v_mfma_f32_16x16x32_bf16 v[72:75], v[220:223], v[120:123], v[72:75]
    v_mfma_f32_16x16x32_bf16 v[76:79], v[220:223], v[124:127], v[76:79]
    v_add_f32 v84, v64, v69
    v_add_f32 v92, v66, v71
    v_cvt_pk_bf16_f32 v92, v84, v92
    v_lshlrev_b32 v84, 16, v92
    v_and_b32 v92, 0xffff0000, v92
    v_max3_f32 v15, v15, v84, v92
    s_waitcnt vmcnt(4)
    s_and_b32 s60, s101, 1
    s_cbranch_scc1 L_bo34
    s_waitcnt vmcnt(3)
L_bo34:
    s_xor_b32 s66, s68, 131072
    buffer_load_dwordx4 v[136:139], v3, s[24:27], s66 offen nt
    s_waitcnt vmcnt(8)
    v_mfma_f32_16x16x32_bf16 v[64:67], v[224:227], v[96:99], 0
    v_mfma_f32_16x16x32_bf16 v[68:71], v[224:227], v[100:103], 0
    v_mfma_f32_16x16x32_bf16 v[64:67], v[228:231], v[104:107], v[64:67]
    v_mfma_f32_16x16x32_bf16 v[68:71], v[228:231], v[108:111], v[68:71]
    v_mfma_f32_16x16x32_bf16 v[64:67], v[232:235], v[112:115], v[64:67]
    v_mfma_f32_16x16x32_bf16 v[68:71], v[232:235], v[116:119], v[68:71]
    v_mfma_f32_16x16x32_bf16 v[64:67], v[236:239], v[120:123], v[64:67]
    v_mfma_f32_16x16x32_bf16 v[68:71], v[236:239], v[124:127], v[68:71]
    v_add_f32 v85, v72, v77
    v_add_f32 v93, v74, v79
    v_cvt_pk_bf16_f32 v93, v85, v93
    v_lshlrev_b32 v85, 16, v93
    v_and_b32 v93, 0xffff0000, v93
    v_max3_f32 v15, v15, v85, v93
    s_waitcnt vmcnt(4)
    s_and_b32 s60, s101, 1
    s_cbranch_scc1 L_bo35
    s_waitcnt vmcnt(2)
L_bo35:
    s_xor_b32 s66, s68, 147456
    buffer_load_dwordx4 v[140:143], v3, s[24:27], s66 offen nt
    s_waitcnt vmcnt(5)
    v_mfma_f32_16x16x32_bf16 v[72:75], v[240:243], v[96:99], 0
    v_mfma_f32_16x16x32_bf16 v[76:79], v[240:243], v[100:103], 0
    v_mfma_f32_16x16x32_bf16 v[72:75], v[244:247], v[104:107], v[72:75]
    v_mfma_f32_16x16x32_bf16 v[76:79], v[244:247], v[108:111], v[76:79]
    v_mfma_f32_16x16x32_bf16 v[72:75], v[248:251], v[112:115], v[72:75]
    v_mfma_f32_16x16x32_bf16 v[76:79], v[248:251], v[116:119], v[76:79]
    v_mfma_f32_16x16x32_bf16 v[72:75], v[252:255], v[120:123], v[72:75]
    v_mfma_f32_16x16x32_bf16 v[76:79], v[252:255], v[124:127], v[76:79]
    v_add_f32 v86, v64, v69
    v_add_f32 v94, v66, v71
    v_cvt_pk_bf16_f32 v94, v86, v94
    v_lshlrev_b32 v86, 16, v94
    v_and_b32 v94, 0xffff0000, v94
    v_max3_f32 v15, v15, v86, v94
    v_and_b32 v12, 15, v1
    v_lshlrev_b32 v12, 5, v12
    s_lshl_b32 s60, s55, 2
    s_add_u32 s60, s60, 106496
    v_add_u32 v13, s60, v12
    v_add_u32 v12, 106496, v12
    v_add_f32 v87, v72, v77
    v_add_f32 v95, v74, v79
    v_cvt_pk_bf16_f32 v95, v87, v95
    v_lshlrev_b32 v87, 16, v95
    v_and_b32 v95, 0xffff0000, v95
    v_max3_f32 v15, v15, v87, v95
    v_mov_b32 v14, v15
    s_nop 1
    v_permlane32_swap_b32 v14, v15
    v_max_f32 v15, v14, v15
    v_mov_b32 v14, v15
    s_nop 1
    v_permlane16_swap_b32 v14, v15
    v_max_f32 v15, v14, v15
    ds_write_b32 v13, v15
    v_mov_b32 v14, 161800
    v_mov_b32 v9, 1
    s_mov_b64 exec, 1
    ds_add_u32 v14, v9
    s_mov_b64 exec, -1
    s_waitcnt vmcnt(3)
    s_and_b32 s60, s101, 1
    s_cbranch_scc1 L_bo36
    s_waitcnt vmcnt(2)
L_bo36:
    s_xor_b32 s66, s68, 65536
    buffer_load_dwordx4 v[144:147], v3, s[24:27], s66 offen nt
    s_waitcnt vmcnt(3)
    s_and_b32 s60, s101, 1
    s_cbranch_scc1 L_bo37
    s_waitcnt vmcnt(2)
L_bo37:
    s_xor_b32 s66, s68, 81920
    buffer_load_dwordx4 v[148:151], v3, s[24:27], s66 offen nt
    s_lshl_b32 s60, s55, 11
    s_add_u32 s60, s60, 73728
    v_add_u32 v13, s60, v4
L_aw2:
    s_sub_u32 s3, s3, 1
    s_cbranch_scc1 L_fin
    v_mov_b32 v9, 161800
    ds_read_b32 v9, v9
    ds_read_b128 v[64:67], v12
    ds_read_b128 v[68:71], v12 offset:16
    s_waitcnt lgkmcnt(0)
    v_readfirstlane_b32 s60, v9
    s_nop 0
    s_cmp_lt_u32 s60, 8
    s_cbranch_scc1 L_aw2
    v_max3_f32 v15, v64, v65, v66
    v_max3_f32 v14, v67, v68, v69
    v_max3_f32 v15, v15, v70, v71
    v_max_f32 v15, v14, v15
    v_mul_f32 v120, s57, v15
    v_fma_f32 v80, v80, s57, -v120
    v_fma_f32 v81, v81, s57, -v120
    v_fma_f32 v82, v82, s57, -v120
    v_fma_f32 v83, v83, s57, -v120
    v_fma_f32 v84, v84, s57, -v120
    v_fma_f32 v85, v85, s57, -v120
    v_fma_f32 v86, v86, s57, -v120
    v_fma_f32 v87, v87, s57, -v120
    v_fma_f32 v88, v88, s57, -v120
    v_fma_f32 v89, v89, s57, -v120
    v_fma_f32 v90, v90, s57, -v120
    v_fma_f32 v91, v91, s57, -v120
    v_fma_f32 v92, v92, s57, -v120
    v_fma_f32 v93, v93, s57, -v120
    v_fma_f32 v94, v94, s57, -v120
    v_fma_f32 v95, v95, s57, -v120
    v_exp_f32 v80, v80
    v_exp_f32 v81, v81
    v_exp_f32 v82, v82
    v_exp_f32 v83, v83
    v_exp_f32 v84, v84
    v_exp_f32 v85, v85
    v_exp_f32 v86, v86
    v_exp_f32 v87, v87
    v_exp_f32 v88, v88
    v_exp_f32 v89, v89
    v_exp_f32 v90, v90
    v_exp_f32 v91, v91
    v_exp_f32 v92, v92
    v_exp_f32 v93, v93
    v_exp_f32 v94, v94
    v_exp_f32 v95, v95
    v_cvt_pk_bf16_f32 v16, v80, v81
    v_cvt_pk_bf16_f32 v17, v82, v83
    v_cvt_pk_bf16_f32 v18, v84, v85
    v_cvt_pk_bf16_f32 v19, v86, v87
    v_cvt_pk_bf16_f32 v20, v88, v89
    v_cvt_pk_bf16_f32 v21, v90, v91
    v_cvt_pk_bf16_f32 v22, v92, v93
    v_cvt_pk_bf16_f32 v23, v94, v95
    ds_write_b128 v13, v[16:19]
    ds_write_b128 v13, v[20:23] offset:1024
    s_waitcnt vmcnt(6)
    v_mov_b32 v14, 161804
    v_mov_b32 v9, 1
    s_mov_b64 exec, 1
    ds_add_u32 v14, v9
    s_mov_b64 exec, -1
    s_waitcnt vmcnt(3)
    s_and_b32 s60, s101, 1
    s_cbranch_scc1 L_bo38
    s_waitcnt vmcnt(2)
L_bo38:
    s_xor_b32 s66, s68, 196608
    buffer_load_dwordx4 v[152:155], v3, s[24:27], s66 offen nt
    s_waitcnt vmcnt(3)
    s_and_b32 s60, s101, 1
    s_cbranch_scc1 L_bo39
    s_waitcnt vmcnt(2)
L_bo39:
    s_xor_b32 s66, s68, 212992
    buffer_load_dwordx4 v[156:159], v3, s[24:27], s66 offen nt
    s_lshl_b32 s60, s9, 13
    s_add_u32 s60, s60, 73728
    v_add_u32 v12, s60, v4
L_aw3:
    s_sub_u32 s3, s3, 1
    s_cbranch_scc1 L_fin
    v_mov_b32 v9, 161804
    ds_read_b32 v9, v9
    ds_read_b128 v[80:83], v12 offset:0
    ds_read_b128 v[84:87], v12 offset:1024
    ds_read_b128 v[88:91], v12 offset:2048
    ds_read_b128 v[92:95], v12 offset:3072
    ds_read_b128 v[96:99], v12 offset:4096
    ds_read_b128 v[100:103], v12 offset:5120
    ds_read_b128 v[104:107], v12 offset:6144
    ds_read_b128 v[108:111], v12 offset:7168
    s_waitcnt lgkmcnt(0)
    v_readfirstlane_b32 s60, v9
    s_nop 0
    s_cmp_lt_u32 s60, 8
    s_cbranch_scc1 L_aw3
    s_mov_b32 s17, 0x40000000
    s_cmp_lg_u32 s10, 0
    s_cbranch_scc1 L_nost
    v_mov_b32 v12, 0x3f803f80
    v_mov_b32 v13, 0x3f803f80
    v_mov_b32 v14, 0x3f803f80
    v_mov_b32 v15, 0x3f803f80
    s_nop 1
    v_mfma_f32_16x16x32_bf16 v[8:11], v[12:15], v[80:83], 0
    v_mfma_f32_16x16x32_bf16 v[8:11], v[12:15], v[84:87], v[8:11]
    v_mfma_f32_16x16x32_bf16 v[8:11], v[12:15], v[88:91], v[8:11]
    v_mfma_f32_16x16x32_bf16 v[8:11], v[12:15], v[92:95], v[8:11]
    v_mfma_f32_16x16x32_bf16 v[8:11], v[12:15], v[96:99], v[8:11]
    v_mfma_f32_16x16x32_bf16 v[8:11], v[12:15], v[100:103], v[8:11]
    v_mfma_f32_16x16x32_bf16 v[8:11], v[12:15], v[104:107], v[8:11]
    v_mfma_f32_16x16x32_bf16 v[8:11], v[12:15], v[108:111], v[8:11]
    s_lshl_b32 s60, s11, 9
    s_lshl_b32 s71, s9, 8
    s_add_u32 s60, s60, s71
    s_add_u32 s17, s60, 4096
    s_nop 3
    v_mov_b32 v8, v120
    v_mov_b32 v11, s56
L_nost:
    s_mov_b64 exec, 0xffff
    s_cmp_eq_u32 s16, 1
    s_cbranch_scc0 L_far2
    buffer_store_dwordx4 v[8:11], v4, s[40:43], s17 offen
L_near2:
    s_mov_b64 exec, -1
    s_waitcnt vmcnt(3)
    s_xor_b32 s66, s68, 4096
    buffer_load_dwordx4 v[160:163], v3, s[24:27], s66 offen nt
    s_lshl_b32 s15, s52, 1
    s_and_b32 s60, s53, 1
    s_add_u32 s15, s15, s60
    s_lshl_b32 s7, s15, 9
    s_lshl_b32 s15, s15, 14
    s_and_b32 s60, s55, 2
    s_lshl_b32 s60, s60, 12
    s_add_u32 s15, s15, s60
    s_and_b32 s60, s55, 1
    s_lshl_b32 s60, s60, 10
    s_add_u32 s15, s15, s60
    s_lshl_b32 s60, s9, 21
    s_add_u32 s15, s15, s60
    s_add_u32 s15, s15, 819200
    s_add_u32 s20, s15, 4096
    s_lshr_b32 s60, s53, 1
    s_lshl_b32 s60, s60, 3
    s_add_u32 s60, s60, s55
    s_lshl_b32 s60, s60, 14
    s_add_u32 s7, s7, s60
    s_add_u32 s7, s7, 294912
    s_lshl_b32 s8, s11, 3
    s_add_u32 s8, s8, s55
    s_lshl_b32 s8, s8, 10
    s_add_u32 s8, s8, 294912
    v_mov_b32 v126, v7
    s_waitcnt vmcnt(3)
    s_xor_b32 s66, s68, 20480
    buffer_load_dwordx4 v[164:167], v3, s[24:27], s66 offen nt
    s_waitcnt vmcnt(3)
    s_xor_b32 s66, s68, 135168
    buffer_load_dwordx4 v[168:171], v3, s[24:27], s66 offen nt
    s_waitcnt vmcnt(4)
    v_perm_b32 v112, v132, v128, s58
    v_perm_b32 v113, v140, v136, s58
    v_perm_b32 v114, v148, v144, s58
    v_perm_b32 v115, v156, v152, s58
    s_nop 1
    v_mfma_f32_16x16x32_bf16 v[16:19], v[112:115], v[80:83], 0
    v_mfma_f32_16x16x32_bf16 v[20:23], v[112:115], v[84:87], 0
    v_perm_b32 v116, v132, v128, s59
    v_perm_b32 v117, v140, v136, s59
    v_perm_b32 v118, v148, v144, s59
    v_perm_b32 v119, v156, v152, s59
    s_nop 1
    v_mfma_f32_16x16x32_bf16 v[24:27], v[116:119], v[80:83], 0
    v_mfma_f32_16x16x32_bf16 v[28:31], v[116:119], v[84:87], 0
    v_perm_b32 v112, v133, v129, s58
    v_perm_b32 v113, v141, v137, s58
    v_perm_b32 v114, v149, v145, s58
    v_perm_b32 v115, v157, v153, s58
    s_nop 1
    v_mfma_f32_16x16x32_bf16 v[32:35], v[112:115], v[80:83], 0
    v_mfma_f32_16x16x32_bf16 v[36:39], v[112:115], v[84:87], 0
    v_perm_b32 v116, v133, v129, s59
    v_perm_b32 v117, v141, v137, s59
    v_perm_b32 v118, v149, v145, s59
    v_perm_b32 v119, v157, v153, s59
    s_nop 1
    v_mfma_f32_16x16x32_bf16 v[40:43], v[116:119], v[80:83], 0
    v_mfma_f32_16x16x32_bf16 v[44:47], v[116:119], v[84:87], 0
    v_perm_b32 v112, v134, v130, s58
    v_perm_b32 v113, v142, v138, s58
    v_perm_b32 v114, v150, v146, s58
    v_perm_b32 v115, v158, v154, s58
    s_nop 1
    v_mfma_f32_16x16x32_bf16 v[48:51], v[112:115], v[80:83], 0
    v_mfma_f32_16x16x32_bf16 v[52:55], v[112:115], v[84:87], 0
    v_perm_b32 v116, v134, v130, s59
    v_perm_b32 v117, v142, v138, s59
    v_perm_b32 v118, v150, v146, s59
    v_perm_b32 v119, v158, v154, s59
    s_nop 1
    v_mfma_f32_16x16x32_bf16 v[56:59], v[116:119], v[80:83], 0
    v_mfma_f32_16x16x32_bf16 v[60:63], v[116:119], v[84:87], 0
    v_perm_b32 v112, v135, v131, s58
    v_perm_b32 v113, v143, v139, s58
    v_perm_b32 v114, v151, v147, s58
    v_perm_b32 v115, v159, v155, s58
    s_nop 1
    v_mfma_f32_16x16x32_bf16 v[64:67], v[112:115], v[80:83], 0
    v_mfma_f32_16x16x32_bf16 v[68:71], v[112:115], v[84:87], 0
    v_perm_b32 v116, v135, v131, s59
    v_perm_b32 v117, v143, v139, s59
    v_perm_b32 v118, v151, v147, s59
    v_perm_b32 v119, v159, v155, s59
    s_nop 1
    v_mfma_f32_16x16x32_bf16 v[72:75], v[116:119], v[80:83], 0
    v_mfma_f32_16x16x32_bf16 v[76:79], v[116:119], v[84:87], 0
    s_waitcnt vmcnt(2)
    s_xor_b32 s66, s68, 151552
    buffer_load_dwordx4 v[172:175], v3, s[24:27], s66 offen nt
    s_waitcnt vmcnt(2)
    s_xor_b32 s66, s68, 69632
    buffer_load_dwordx4 v[176:179], v3, s[24:27], s66 offen nt
    s_waitcnt vmcnt(2)
    s_xor_b32 s66, s68, 86016
    buffer_load_dwordx4 v[180:183], v3, s[24:27], s66 offen nt
    s_waitcnt vmcnt(2)
    s_xor_b32 s66, s68, 200704
    buffer_load_dwordx4 v[184:187], v3, s[24:27], s66 offen nt
    s_waitcnt vmcnt(2)
    s_xor_b32 s66, s68, 217088
    buffer_load_dwordx4 v[188:191], v3, s[24:27], s66 offen nt
    s_lshl_b32 s60, s52, 11
    s_add_u32 s60, s60, 4096
    s_cmp_eq_u32 s55, 7
    s_cselect_b32 s60, s60, 0x40000000
    buffer_load_dwordx4 v[8:11], v4, s[40:43], s60 offen sc1
    s_xor_b32 s71, s5, 1
    s_lshl_b32 s71, s71, 21
    s_add_u32 s71, s71, s60
    v_and_b32 v127, 7, v1
    v_lshlrev_b32 v127, 8, v127
    buffer_load_dword v127, v127, s[44:47], s71 offen offset:12 sc1
    buffer_load_dwordx4 v[12:15], v4, s[40:43], s60 offen offset:1024 sc1
    s_waitcnt vmcnt(5)
    s_xor_b32 s66, s68, 32768
    buffer_load_dwordx4 v[192:195], v3, s[24:27], s66 offen nt
    s_waitcnt vmcnt(5)
    s_xor_b32 s66, s68, 49152
    buffer_load_dwordx4 v[196:199], v3, s[24:27], s66 offen nt
    s_waitcnt vmcnt(5)
    s_xor_b32 s66, s68, 163840
    buffer_load_dwordx4 v[200:203], v3, s[24:27], s66 offen nt
    s_waitcnt vmcnt(6)
    v_perm_b32 v112, v164, v160, s58
    v_perm_b32 v113, v172, v168, s58
    v_perm_b32 v114, v180, v176, s58
    v_perm_b32 v115, v188, v184, s58
    s_nop 1
    v_mfma_f32_16x16x32_bf16 v[16:19], v[112:115], v[88:91], v[16:19]
    v_mfma_f32_16x16x32_bf16 v[20:23], v[112:115], v[92:95], v[20:23]
    v_perm_b32 v116, v164, v160, s59
    v_perm_b32 v117, v172, v168, s59
    v_perm_b32 v118, v180, v176, s59
    v_perm_b32 v119, v188, v184, s59
    s_nop 1
    v_mfma_f32_16x16x32_bf16 v[24:27], v[116:119], v[88:91], v[24:27]
    v_mfma_f32_16x16x32_bf16 v[28:31], v[116:119], v[92:95], v[28:31]
    v_perm_b32 v112, v165, v161, s58
    v_perm_b32 v113, v173, v169, s58
    v_perm_b32 v114, v181, v177, s58
    v_perm_b32 v115, v189, v185, s58
    s_nop 1
    v_mfma_f32_16x16x32_bf16 v[32:35], v[112:115], v[88:91], v[32:35]
    v_mfma_f32_16x16x32_bf16 v[36:39], v[112:115], v[92:95], v[36:39]
    v_perm_b32 v116, v165, v161, s59
    v_perm_b32 v117, v173, v169, s59
    v_perm_b32 v118, v181, v177, s59
    v_perm_b32 v119, v189, v185, s59
    s_nop 1
    v_mfma_f32_16x16x32_bf16 v[40:43], v[116:119], v[88:91], v[40:43]
    v_mfma_f32_16x16x32_bf16 v[44:47], v[116:119], v[92:95], v[44:47]
    v_perm_b32 v112, v166, v162, s58
    v_perm_b32 v113, v174, v170, s58
    v_perm_b32 v114, v182, v178, s58
    v_perm_b32 v115, v190, v186, s58
    s_nop 1
    v_mfma_f32_16x16x32_bf16 v[48:51], v[112:115], v[88:91], v[48:51]
    v_mfma_f32_16x16x32_bf16 v[52:55], v[112:115], v[92:95], v[52:55]
    v_perm_b32 v116, v166, v162, s59
    v_perm_b32 v117, v174, v170, s59
    v_perm_b32 v118, v182, v178, s59
    v_perm_b32 v119, v190, v186, s59
    s_nop 1
    v_mfma_f32_16x16x32_bf16 v[56:59], v[116:119], v[88:91], v[56:59]
    v_mfma_f32_16x16x32_bf16 v[60:63], v[116:119], v[92:95], v[60:63]
    v_perm_b32 v112, v167, v163, s58
    v_perm_b32 v113, v175, v171, s58
    v_perm_b32 v114, v183, v179, s58
    v_perm_b32 v115, v191, v187, s58
    s_nop 1
    v_mfma_f32_16x16x32_bf16 v[64:67], v[112:115], v[88:91], v[64:67]
    v_mfma_f32_16x16x32_bf16 v[68:71], v[112:115], v[92:95], v[68:71]
    v_perm_b32 v116, v167, v163, s59
    v_perm_b32 v117, v175, v171, s59
    v_perm_b32 v118, v183, v179, s59
    v_perm_b32 v119, v191, v187, s59
    s_nop 1
    v_mfma_f32_16x16x32_bf16 v[72:75], v[116:119], v[88:91], v[72:75]
    v_mfma_f32_16x16x32_bf16 v[76:79], v[116:119], v[92:95], v[76:79]
    s_waitcnt vmcnt(2)
    s_xor_b32 s66, s68, 180224
    buffer_load_dwordx4 v[204:207], v3, s[24:27], s66 offen nt
    s_waitcnt vmcnt(4)
    s_cmp_lg_u32 s55, 7
    s_cbranch_scc1 L_nosc
L_chk_s:
    v_cmpx_eq_u32 vcc, s56, v11
    v_cmpx_eq_u32 vcc, s56, v15
    v_cmpx_eq_u32 vcc, s56, v127
    s_nop 0
    s_cmp_eq_u64 exec, -1
    s_mov_b64 exec, -1
    s_cbranch_scc0 L_retry_s
    v_max_f32 v10, v8, v12
    v_mov_b32 v11, v10
    s_nop 1
    v_permlane32_swap_b32 v11, v10
    v_max_f32 v10, v10, v11
    v_mov_b32 v11, v10
    s_nop 1
    v_permlane16_swap_b32 v11, v10
    v_max_f32 v10, v10, v11
    v_sub_f32 v8, v8, v10
    v_sub_f32 v12, v12, v10
    v_sub_f32 v14, v120, v10
    v_exp_f32 v8, v8
    v_exp_f32 v12, v12
    v_exp_f32 v14, v14
    v_mul_f32 v9, v8, v9
    v_fmac_f32 v9, v12, v13
    v_mov_b32 v11, v9
    s_nop 1
    v_permlane32_swap_b32 v11, v9
    v_add_f32 v9, v9, v11
    v_mov_b32 v11, v9
    s_nop 1
    v_permlane16_swap_b32 v11, v9
    v_add_f32 v9, v9, v11
    v_rcp_f32 v9, v9
    v_and_b32 v8, 15, v1
    v_lshlrev_b32 v8, 2, v8
    v_add_u32 v8, 107008, v8
    v_mul_f32 v9, v9, v14
    ds_write_b32 v8, v9
L_nosc:
    s_waitcnt vmcnt(2)
    s_xor_b32 s66, s68, 98304
    buffer_load_dwordx4 v[208:211], v3, s[24:27], s66 offen nt
    s_waitcnt vmcnt(2)
    s_xor_b32 s66, s68, 114688
    buffer_load_dwordx4 v[212:215], v3, s[24:27], s66 offen nt
    s_waitcnt vmcnt(2)
    s_xor_b32 s66, s68, 229376
    buffer_load_dwordx4 v[216:219], v3, s[24:27], s66 offen nt
    s_waitcnt vmcnt(2)
    s_xor_b32 s66, s68, 245760
    buffer_load_dwordx4 v[220:223], v3, s[24:27], s66 offen nt
    s_waitcnt vmcnt(2)
    s_xor_b32 s66, s68, 36864
    buffer_load_dwordx4 v[224:227], v3, s[24:27], s66 offen nt
    s_waitcnt vmcnt(2)
    s_xor_b32 s66, s68, 53248
    buffer_load_dwordx4 v[228:231], v3, s[24:27], s66 offen nt
    s_waitcnt vmcnt(2)
    s_xor_b32 s66, s68, 167936
    buffer_load_dwordx4 v[232:235], v3, s[24:27], s66 offen nt
    s_waitcnt vmcnt(3)
    v_perm_b32 v112, v196, v192, s58
    v_perm_b32 v113, v204, v200, s58
    v_perm_b32 v114, v212, v208, s58
    v_perm_b32 v115, v220, v216, s58
    s_nop 1
    v_mfma_f32_16x16x32_bf16 v[16:19], v[112:115], v[96:99], v[16:19]
    v_mfma_f32_16x16x32_bf16 v[20:23], v[112:115], v[100:103], v[20:23]
    v_perm_b32 v116, v196, v192, s59
    v_perm_b32 v117, v204, v200, s59
    v_perm_b32 v118, v212, v208, s59
    v_perm_b32 v119, v220, v216, s59
    s_nop 1
    v_mfma_f32_16x16x32_bf16 v[24:27], v[116:119], v[96:99], v[24:27]
    v_mfma_f32_16x16x32_bf16 v[28:31], v[116:119], v[100:103], v[28:31]
    v_perm_b32 v112, v197, v193, s58
    v_perm_b32 v113, v205, v201, s58
    v_perm_b32 v114, v213, v209, s58
    v_perm_b32 v115, v221, v217, s58
    s_nop 1
    v_mfma_f32_16x16x32_bf16 v[32:35], v[112:115], v[96:99], v[32:35]
    v_mfma_f32_16x16x32_bf16 v[36:39], v[112:115], v[100:103], v[36:39]
    v_perm_b32 v116, v197, v193, s59
    v_perm_b32 v117, v205, v201, s59
    v_perm_b32 v118, v213, v209, s59
    v_perm_b32 v119, v221, v217, s59
    s_nop 1
    v_mfma_f32_16x16x32_bf16 v[40:43], v[116:119], v[96:99], v[40:43]
    v_mfma_f32_16x16x32_bf16 v[44:47], v[116:119], v[100:103], v[44:47]
    v_perm_b32 v112, v198, v194, s58
    v_perm_b32 v113, v206, v202, s58
    v_perm_b32 v114, v214, v210, s58
    v_perm_b32 v115, v222, v218, s58
    s_nop 1
    v_mfma_f32_16x16x32_bf16 v[48:51], v[112:115], v[96:99], v[48:51]
    v_mfma_f32_16x16x32_bf16 v[52:55], v[112:115], v[100:103], v[52:55]
    v_perm_b32 v116, v198, v194, s59
    v_perm_b32 v117, v206, v202, s59
    v_perm_b32 v118, v214, v210, s59
    v_perm_b32 v119, v222, v218, s59
    s_nop 1
    v_mfma_f32_16x16x32_bf16 v[56:59], v[116:119], v[96:99], v[56:59]
    v_mfma_f32_16x16x32_bf16 v[60:63], v[116:119], v[100:103], v[60:63]
    v_perm_b32 v112, v199, v195, s58
    v_perm_b32 v113, v207, v203, s58
    v_perm_b32 v114, v215, v211, s58
    v_perm_b32 v115, v223, v219, s58
    s_nop 1
    v_mfma_f32_16x16x32_bf16 v[64:67], v[112:115], v[96:99], v[64:67]
    v_mfma_f32_16x16x32_bf16 v[68:71], v[112:115], v[100:103], v[68:71]
    v_perm_b32 v116, v199, v195, s59
    v_perm_b32 v117, v207, v203, s59
    v_perm_b32 v118, v215, v211, s59
    v_perm_b32 v119, v223, v219, s59
    s_nop 1
    v_mfma_f32_16x16x32_bf16 v[72:75], v[116:119], v[96:99], v[72:75]
    v_mfma_f32_16x16x32_bf16 v[76:79], v[116:119], v[100:103], v[76:79]
    s_waitcnt vmcnt(2)
    s_xor_b32 s66, s68, 184320
    buffer_load_dwordx4 v[236:239], v3, s[24:27], s66 offen nt
    s_waitcnt vmcnt(2)
    s_xor_b32 s66, s68, 102400
    buffer_load_dwordx4 v[240:243], v3, s[24:27], s66 offen nt
    v_lshrrev_b32 v13, 4, v1
    s_lshl_b32 s60, s55, 11
    s_add_u32 s71, s60, 90112
    v_add_u32 v2, s71, v4
    s_xor_b32 s60, s60, 0x2000
    s_add_u32 s71, s60, 90112
    v_add_u32 v196, s71, v4
    v_and_b32 v14, 15, v1
    v_lshlrev_b32 v121, 2, v14
    v_add_u32 v121, 107008, v121
    v_mul_u32_u24 v12, 528, v14
    v_lshl_add_u32 v7, v13, 4, v12
    v_add_u32 v7, 107520, v7
    v_and_b32 v12, 7, v1
    v_mul_u32_u24 v12, 528, v12
    v_lshl_add_u32 v197, v13, 5, v12
    v_and_b32 v12, 8, v1
    v_lshl_add_u32 v197, v12, 5, v197
    s_mul_i32 s60, s9, 4224
    s_and_b32 s71, s55, 2
    s_lshl_b32 s71, s71, 6
    s_add_u32 s60, s60, s71
    s_and_b32 s71, s55, 1
    s_lshl_b32 s71, s71, 4
    s_add_u32 s60, s60, s71
    s_add_u32 s60, s60, 107520
    v_add_u32 v197, s60, v197
    v_lshrrev_b32 v12, 5, v1
    v_and_b32 v0, 0x1f0, v4
    v_lshl_add_u32 v0, v12, 13, v0
    s_bfe_u32 s60, s56, 0x80000
    v_mov_b32 v192, s60
    s_bfe_u32 s60, s56, 0x80008
    v_mov_b32 v193, s60
    s_bfe_u32 s60, s56, 0x80010
    v_mov_b32 v194, s60
    s_bfe_u32 s60, s56, 0x80018
    v_mov_b32 v195, s60
    s_mov_b32 s65, 0xffffff00
    s_mov_b32 s67, 0x0c0c0400
    s_mov_b32 s63, 0x3f80
    s_mov_b32 s64, 0x3f800000
    s_lshr_b32 s60, s61, 1
    s_lshl_b32 s60, s60, 3
    s_add_u32 s60, s60, s55
    s_cmp_lt_u32 s60, 28
    s_cselect_b32 s12, 1, 0
    s_lshl_b32 s60, s5, 5
    s_add_u32 s60, s60, s11
    s_cmp_lt_u32 s60, 56
    s_cselect_b32 s13, 1, 0
    s_lshl_b32 s60, s60, 4
    s_lshr_b32 s61, s54, 1
    s_mul_i32 s61, s61, 14336
    s_add_u32 s61, s61, s60
    v_mul_u32_u24 v200, 896, v14
    v_lshl_add_u32 v200, v12, 2, v200
    v_bfe_u32 v15, v1, 4, 1
    v_lshl_add_u32 v200, v15, 3, v200
    s_lshl_b32 s60, s55, 9
    s_add_u32 s60, s60, 116224
    v_lshlrev_b32 v199, 3, v1
    v_add_u32 v198, s60, v199
    v_add_u32 v199, 116224, v199
    s_waitcnt vmcnt(2)
    s_xor_b32 s66, s68, 118784
    buffer_load_dwordx4 v[244:247], v3, s[24:27], s66 offen nt
    s_waitcnt vmcnt(2)
    s_xor_b32 s66, s68, 233472
    buffer_load_dwordx4 v[248:251], v3, s[24:27], s66 offen nt
    s_waitcnt vmcnt(2)
    s_xor_b32 s66, s68, 249856
    buffer_load_dwordx4 v[252:255], v3, s[24:27], s66 offen nt
    v_and_b32 v125, 7, v1
    v_lshlrev_b32 v125, 7, v125
    buffer_load_dword v127, v125, s[40:43], s14 offen sc1
    s_add_u32 m0, s4, 0
    s_add_u32 s60, s6, 0
    buffer_load_dwordx4 v5, s[36:39], s60 offen  lds
    s_add_u32 m0, s4, 1024
    s_add_u32 s60, s6, 7168
    buffer_load_dwordx4 v6, s[36:39], s60 offen  lds
    s_add_u32 m0, s4, 2048
    s_add_u32 s60, s6, 14336
    buffer_load_dwordx4 v5, s[36:39], s60 offen  lds
    s_add_u32 m0, s4, 3072
    s_add_u32 s60, s6, 21504
    buffer_load_dwordx4 v6, s[36:39], s60 offen  lds
    s_add_u32 m0, s4, 4096
    s_add_u32 s60, s6, 28672
    buffer_load_dwordx4 v5, s[36:39], s60 offen  lds
    s_add_u32 m0, s4, 5120
    s_add_u32 s60, s6, 35840
    buffer_load_dwordx4 v6, s[36:39], s60 offen  lds
    s_add_u32 m0, s4, 6144
    s_add_u32 s60, s6, 43008
    buffer_load_dwordx4 v5, s[36:39], s60 offen  lds
    s_add_u32 m0, s4, 7168
    s_add_u32 s60, s6, 50176
    buffer_load_dwordx4 v6, s[36:39], s60 offen  lds
    s_waitcnt vmcnt(9)
    v_perm_b32 v112, v228, v224, s58
    v_perm_b32 v113, v236, v232, s58
    v_perm_b32 v114, v244, v240, s58
    v_perm_b32 v115, v252, v248, s58
    s_nop 1
    v_mfma_f32_16x16x32_bf16 v[16:19], v[112:115], v[104:107], v[16:19]
    v_mfma_f32_16x16x32_bf16 v[20:23], v[112:115], v[108:111], v[20:23]
    v_perm_b32 v116, v228, v224, s59
    v_perm_b32 v117, v236, v232, s59
    v_perm_b32 v118, v244, v240, s59
    v_perm_b32 v119, v252, v248, s59
    s_nop 1
    v_mfma_f32_16x16x32_bf16 v[24:27], v[116:119], v[104:107], v[24:27]
    v_mfma_f32_16x16x32_bf16 v[28:31], v[116:119], v[108:111], v[28:31]
    v_perm_b32 v112, v229, v225, s58
    v_perm_b32 v113, v237, v233, s58
    v_perm_b32 v114, v245, v241, s58
    v_perm_b32 v115, v253, v249, s58
    s_nop 1
    v_mfma_f32_16x16x32_bf16 v[32:35], v[112:115], v[104:107], v[32:35]
    v_mfma_f32_16x16x32_bf16 v[36:39], v[112:115], v[108:111], v[36:39]
    v_perm_b32 v116, v229, v225, s59
    v_perm_b32 v117, v237, v233, s59
    v_perm_b32 v118, v245, v241, s59
    v_perm_b32 v119, v253, v249, s59
    s_nop 1
    v_mfma_f32_16x16x32_bf16 v[40:43], v[116:119], v[104:107], v[40:43]
    v_mfma_f32_16x16x32_bf16 v[44:47], v[116:119], v[108:111], v[44:47]
    v_perm_b32 v112, v230, v226, s58
    v_perm_b32 v113, v238, v234, s58
    v_perm_b32 v114, v246, v242, s58
    v_perm_b32 v115, v254, v250, s58
    s_nop 1
    v_mfma_f32_16x16x32_bf16 v[48:51], v[112:115], v[104:107], v[48:51]
    v_mfma_f32_16x16x32_bf16 v[52:55], v[112:115], v[108:111], v[52:55]
    v_perm_b32 v116, v230, v226, s59
    v_perm_b32 v117, v238, v234, s59
    v_perm_b32 v118, v246, v242, s59
    v_perm_b32 v119, v254, v250, s59
    s_nop 1
    v_mfma_f32_16x16x32_bf16 v[56:59], v[116:119], v[104:107], v[56:59]
    v_mfma_f32_16x16x32_bf16 v[60:63], v[116:119], v[108:111], v[60:63]
    v_perm_b32 v112, v231, v227, s58
    v_perm_b32 v113, v239, v235, s58
    v_perm_b32 v114, v247, v243, s58
    v_perm_b32 v115, v255, v251, s58
    s_nop 1
    v_mfma_f32_16x16x32_bf16 v[64:67], v[112:115], v[104:107], v[64:67]
    v_mfma_f32_16x16x32_bf16 v[68:71], v[112:115], v[108:111], v[68:71]
    v_perm_b32 v116, v231, v227, s59
    v_perm_b32 v117, v239, v235, s59
    v_perm_b32 v118, v247, v243, s59
    v_perm_b32 v119, v255, v251, s59
    s_nop 1
    v_mfma_f32_16x16x32_bf16 v[72:75], v[116:119], v[104:107], v[72:75]
    v_mfma_f32_16x16x32_bf16 v[76:79], v[116:119], v[108:111], v[76:79]
    v_add_f32 v88, v18, v23
    v_add_f32 v89, v26, v31
    v_add_f32 v90, v34, v39
    v_add_f32 v91, v42, v47
    v_add_f32 v92, v50, v55
    v_add_f32 v93, v58, v63
    v_add_f32 v94, v66, v71
    s_nop 0
    v_add_f32 v95, v74, v79
    ds_write_b128 v2, v[88:91]
    ds_write_b128 v2, v[92:95] offset:1024
    v_add_f32 v80, v16, v21
    v_add_f32 v81, v24, v29
    v_add_f32 v82, v32, v37
    v_add_f32 v83, v40, v45
    v_add_f32 v84, v48, v53
    v_add_f32 v85, v56, v61
    v_add_f32 v86, v64, v69
    v_add_f32 v87, v72, v77
    s_waitcnt vmcnt(0)
    s_waitcnt lgkmcnt(0)
    s_barrier
    ds_read_b128 v[96:99], v196
    ds_read_b128 v[100:103], v196 offset:1024
    ds_read_b32 v104, v121
    s_waitcnt lgkmcnt(0)
    v_pk_add_f32 v[80:81], v[80:81], v[96:97]
    v_pk_add_f32 v[82:83], v[82:83], v[98:99]
    v_pk_add_f32 v[84:85], v[84:85], v[100:101]
    v_pk_add_f32 v[86:87], v[86:87], v[102:103]
    v_pk_mul_f32 v[80:81], v[80:81], v[104:105] op_sel_hi:[1,0]
    v_pk_mul_f32 v[82:83], v[82:83], v[104:105] op_sel_hi:[1,0]
    v_pk_mul_f32 v[84:85], v[84:85], v[104:105] op_sel_hi:[1,0]
    v_pk_mul_f32 v[86:87], v[86:87], v[104:105] op_sel_hi:[1,0]
    v_cvt_pk_bf16_f32 v88, v80, v81
    v_cvt_pk_bf16_f32 v89, v82, v83
    v_cvt_pk_bf16_f32 v90, v84, v85
    v_cvt_pk_bf16_f32 v91, v86, v87
    v_min_u32 v91, -2, v91
    s_cmp_eq_u32 s16, 1
    s_cbranch_scc0 L_far3
    buffer_store_dwordx4 v[88:91], v4, s[40:43], s14 offen
L_near3:
    s_lshl_b32 s60, s9, 15
    s_add_u32 s60, s60, 8192
    s_lshl_b32 s71, s10, 5
    v_xor_b32 v10, s71, v126
    v_add_u32 v10, s60, v10
    ds_read_b64_tr_b16 v[128:129], v10 offset:0
    ds_read_b64_tr_b16 v[130:131], v10 offset:512
    ds_read_b64_tr_b16 v[132:133], v10 offset:4096
    ds_read_b64_tr_b16 v[134:135], v10 offset:4608
    ds_read_b64_tr_b16 v[136:137], v10 offset:8192
    ds_read_b64_tr_b16 v[138:139], v10 offset:8704
    ds_read_b64_tr_b16 v[140:141], v10 offset:12288
    ds_read_b64_tr_b16 v[142:143], v10 offset:12800
    ds_read_b64_tr_b16 v[144:145], v10 offset:16384
    ds_read_b64_tr_b16 v[146:147], v10 offset:16896
    ds_read_b64_tr_b16 v[148:149], v10 offset:20480
    ds_read_b64_tr_b16 v[150:151], v10 offset:20992
    ds_read_b64_tr_b16 v[152:153], v10 offset:24576
    ds_read_b64_tr_b16 v[154:155], v10 offset:25088
    ds_read_b64_tr_b16 v[156:157], v10 offset:28672
    ds_read_b64_tr_b16 v[158:159], v10 offset:29184
    s_waitcnt vmcnt(0)
    buffer_load_dwordx4 v[16:19], v4, s[44:47], s15 offen offset:0 sc1
    buffer_load_dwordx4 v[20:23], v4, s[44:47], s15 offen offset:2048 sc1
    buffer_load_dwordx4 v[24:27], v4, s[44:47], s20 offen offset:0 sc1
    buffer_load_dwordx4 v[28:31], v4, s[44:47], s20 offen offset:2048 sc1
    s_waitcnt vmcnt(0)
L_chk_h:
    v_max_u32 v8, v19, v23
    v_max3_u32 v8, v8, v27, v31
    v_cmp_eq_u32 vcc, -1, v8
    s_cbranch_vccnz L_retry_h
    v_lshlrev_b32 v32, 16, v16
    v_and_b32 v33, 0xffff0000, v16
    v_lshlrev_b32 v34, 16, v20
    v_and_b32 v35, 0xffff0000, v20
    v_lshlrev_b32 v36, 16, v24
    v_and_b32 v37, 0xffff0000, v24
    v_lshlrev_b32 v38, 16, v28
    v_and_b32 v39, 0xffff0000, v28
    v_pk_add_f32 v[32:33], v[32:33], v[34:35]
    v_pk_add_f32 v[36:37], v[36:37], v[38:39]
    v_pk_add_f32 v[32:33], v[32:33], v[36:37]
    v_cvt_pk_bf16_f32 v64, v32, v33
    v_lshlrev_b32 v40, 16, v17
    v_and_b32 v41, 0xffff0000, v17
    v_lshlrev_b32 v42, 16, v21
    v_and_b32 v43, 0xffff0000, v21
    v_lshlrev_b32 v44, 16, v25
    v_and_b32 v45, 0xffff0000, v25
    v_lshlrev_b32 v46, 16, v29
    v_and_b32 v47, 0xffff0000, v29
    v_pk_add_f32 v[40:41], v[40:41], v[42:43]
    v_pk_add_f32 v[44:45], v[44:45], v[46:47]
    v_pk_add_f32 v[40:41], v[40:41], v[44:45]
    v_cvt_pk_bf16_f32 v65, v40, v41
    v_lshlrev_b32 v48, 16, v18
    v_and_b32 v49, 0xffff0000, v18
    v_lshlrev_b32 v50, 16, v22
    v_and_b32 v51, 0xffff0000, v22
    v_lshlrev_b32 v52, 16, v26
    v_and_b32 v53, 0xffff0000, v26
    v_lshlrev_b32 v54, 16, v30
    v_and_b32 v55, 0xffff0000, v30
    v_pk_add_f32 v[48:49], v[48:49], v[50:51]
    v_pk_add_f32 v[52:53], v[52:53], v[54:55]
    v_pk_add_f32 v[48:49], v[48:49], v[52:53]
    v_cvt_pk_bf16_f32 v66, v48, v49
    v_lshlrev_b32 v56, 16, v19
    v_and_b32 v57, 0xffff0000, v19
    v_lshlrev_b32 v58, 16, v23
    v_and_b32 v59, 0xffff0000, v23
    v_lshlrev_b32 v60, 16, v27
    v_and_b32 v61, 0xffff0000, v27
    v_lshlrev_b32 v62, 16, v31
    v_and_b32 v63, 0xffff0000, v31
    v_pk_add_f32 v[56:57], v[56:57], v[58:59]
    v_pk_add_f32 v[60:61], v[60:61], v[62:63]
    v_pk_add_f32 v[56:57], v[56:57], v[60:61]
    v_cvt_pk_bf16_f32 v67, v56, v57
    ds_write_b128 v197, v[64:67]
    s_waitcnt lgkmcnt(0)
    s_barrier
    s_cmp_eq_u32 s12, 0
    s_cbranch_scc1 L_nopub
    ds_read_b128 v[16:19], v7 offset:0
    ds_read_b128 v[20:23], v7 offset:64
    ds_read_b128 v[24:27], v7 offset:128
    ds_read_b128 v[28:31], v7 offset:192
    ds_read_b128 v[32:35], v7 offset:256
    ds_read_b128 v[36:39], v7 offset:320
    ds_read_b128 v[40:43], v7 offset:384
    ds_read_b128 v[44:47], v7 offset:448
    s_waitcnt lgkmcnt(7)
    v_mfma_f32_16x16x32_bf16 v[48:51], v[128:131], v[16:19], 0
    s_waitcnt lgkmcnt(6)
    v_mfma_f32_16x16x32_bf16 v[48:51], v[132:135], v[20:23], v[48:51]
    s_waitcnt lgkmcnt(5)
    v_mfma_f32_16x16x32_bf16 v[48:51], v[136:139], v[24:27], v[48:51]
    s_waitcnt lgkmcnt(4)
    v_mfma_f32_16x16x32_bf16 v[48:51], v[140:143], v[28:31], v[48:51]
    s_waitcnt lgkmcnt(3)
    v_mfma_f32_16x16x32_bf16 v[48:51], v[144:147], v[32:35], v[48:51]
    s_waitcnt lgkmcnt(2)
    v_mfma_f32_16x16x32_bf16 v[48:51], v[148:151], v[36:39], v[48:51]
    s_waitcnt lgkmcnt(1)
    v_mfma_f32_16x16x32_bf16 v[48:51], v[152:155], v[40:43], v[48:51]
    s_waitcnt lgkmcnt(0)
    v_mfma_f32_16x16x32_bf16 v[48:51], v[156:159], v[44:47], v[48:51]
    s_nop 7
    v_and_or_b32 v48, v48, s65, v192
    v_and_or_b32 v49, v49, s65, v193
    v_and_or_b32 v50, v50, s65, v194
    v_and_or_b32 v51, v51, s65, v195
    buffer_store_dwordx4 v[48:51], v0, s[40:43], s7 offen sc1
L_nopub:
    s_waitcnt vmcnt(0)
    s_cmp_eq_u32 s13, 0
    s_cbranch_scc1 L_fin
    buffer_load_dwordx4 v[80:83], v4, s[40:43], s8 offen sc1
    s_waitcnt vmcnt(0)
L_chk_o:
    v_perm_b32 v8, v81, v80, s67
    v_perm_b32 v9, v83, v82, s67
    v_lshl_or_b32 v8, v9, 16, v8
    v_cmp_ne_u32 vcc, s56, v8
    s_cbranch_vccnz L_retry_o
    v_and_b32 v80, s65, v80
    v_and_b32 v81, s65, v81
    v_and_b32 v82, s65, v82
    v_and_b32 v83, s65, v83
    s_nop 0
    v_permlane32_swap_b32 v80, v82
    v_permlane32_swap_b32 v81, v83
    v_add_f32 v16, v80, v82
    v_add_f32 v17, v81, v83
    ds_write_b64 v198, v[16:17]
    s_waitcnt lgkmcnt(0)
    s_barrier
    s_cmp_lg_u32 s55, 0
    s_cbranch_scc1 L_fin
    ds_read_b64 v[16:17], v199 offset:0
    ds_read_b64 v[18:19], v199 offset:512
    ds_read_b64 v[20:21], v199 offset:1024
    ds_read_b64 v[22:23], v199 offset:1536
    ds_read_b64 v[24:25], v199 offset:2048
    ds_read_b64 v[26:27], v199 offset:2560
    ds_read_b64 v[28:29], v199 offset:3072
    ds_read_b64 v[30:31], v199 offset:3584
    s_waitcnt lgkmcnt(0)
    v_add_f32 v16, v16, v18
    v_add_f32 v17, v17, v19
    v_add_f32 v20, v20, v22
    v_add_f32 v21, v21, v23
    v_add_f32 v24, v24, v26
    v_add_f32 v25, v25, v27
    v_add_f32 v28, v28, v30
    v_add_f32 v29, v29, v31
    v_add_f32 v16, v16, v20
    v_add_f32 v17, v17, v21
    v_add_f32 v24, v24, v28
    v_add_f32 v25, v25, v29
    v_add_f32 v16, v16, v24
    v_add_f32 v17, v17, v25
    v_cvt_pk_bf16_f32 v16, v16, v17
    buffer_store_dword v16, v200, s[48:51], s61 offen
    s_and_b32 s60, s2, 63
    s_cmp_lg_u32 s60, 0
    s_cbranch_scc1 L_fin
    v_mov_b32 v9, s56
    v_mov_b32 v8, 0
    s_mov_b64 exec, 1
    buffer_store_dword v9, v8, s[44:47], 0 offen sc1
    s_mov_b64 exec, -1
L_fin:
    s_endpgm
L_retry_q:
    s_sub_u32 s3, s3, 1
    s_cbranch_scc1 L_fin
    s_sleep 2
    s_lshl_b32 s60, s52, 3
    s_add_u32 s60, s60, s55
    s_lshl_b32 s60, s60, 12
    s_and_b32 s71, s54, 1
    s_lshl_b32 s71, s71, 11
    s_add_u32 s60, s60, s71
    s_add_u32 s60, s60, 32768
    buffer_load_dwordx4 v[16:19], v4, s[44:47], s60 offen sc1
    buffer_load_dwordx4 v[20:23], v4, s[44:47], s60 offen offset:1024 sc1
    s_waitcnt vmcnt(0)
    s_branch L_chk_q
L_retry_s:
    s_sub_u32 s3, s3, 1
    s_cbranch_scc1 L_fin
    s_sleep 2
    s_lshl_b32 s60, s52, 11
    s_add_u32 s60, s60, 4096
    s_cmp_eq_u32 s55, 7
    s_cselect_b32 s60, s60, 0x40000000
    buffer_load_dwordx4 v[8:11], v4, s[40:43], s60 offen sc1
    s_xor_b32 s71, s5, 1
    s_lshl_b32 s71, s71, 21
    s_add_u32 s71, s71, s60
    v_and_b32 v127, 7, v1
    v_lshlrev_b32 v127, 8, v127
    buffer_load_dword v127, v127, s[44:47], s71 offen offset:12 sc1
    buffer_load_dwordx4 v[12:15], v4, s[40:43], s60 offen offset:1024 sc1
    s_waitcnt vmcnt(0)
    s_branch L_chk_s
L_retry_h:
    s_sub_u32 s3, s3, 1
    s_cbranch_scc1 L_fin
    v_cmp_eq_u32 vcc, -1, v19
    s_cbranch_vccz L_hs0
    buffer_load_dwordx4 v[16:19], v4, s[44:47], s15 offen offset:0 sc1
L_hs0:
    v_cmp_eq_u32 vcc, -1, v23
    s_cbranch_vccz L_hs1
    buffer_load_dwordx4 v[20:23], v4, s[44:47], s15 offen offset:2048 sc1
L_hs1:
    v_cmp_eq_u32 vcc, -1, v27
    s_cbranch_vccz L_hs2
    buffer_load_dwordx4 v[24:27], v4, s[44:47], s20 offen offset:0 sc1
L_hs2:
    v_cmp_eq_u32 vcc, -1, v31
    s_cbranch_vccz L_hs3
    buffer_load_dwordx4 v[28:31], v4, s[44:47], s20 offen offset:2048 sc1
L_hs3:
    s_waitcnt vmcnt(0)
    s_branch L_chk_h
L_retry_o:
    s_sub_u32 s3, s3, 1
    s_cbranch_scc1 L_fin
    buffer_load_dwordx4 v[80:83], v4, s[40:43], s8 offen sc1
    s_waitcnt vmcnt(0)
    s_branch L_chk_o
L_far0:
    buffer_store_dwordx4 v[16:19], v12, s[44:47], s17 offen sc1
    s_branch L_near0
L_far1:
    buffer_store_dwordx4 v[24:27], v4, s[40:43], s14 offen sc1
    s_branch L_near1
L_far2:
    buffer_store_dwordx4 v[8:11], v4, s[40:43], s17 offen sc1
    s_branch L_near2
L_far3:
    buffer_store_dwordx4 v[88:91], v4, s[40:43], s14 offen sc1
    s_branch L_near3
L_end:
    s_endpgm
.section .rodata,"a"
.p2align 6
.amdhsa_kernel standalone__sliding_block_cached__sampling_kernel
  .amdhsa_next_free_vgpr 256
  .amdhsa_next_free_sgpr 102
  .amdhsa_accum_offset 256
  .amdhsa_group_segment_fixed_size 0
  .amdhsa_kernarg_size 64
  .amdhsa_user_sgpr_count 2
  .amdhsa_user_sgpr_kernarg_segment_ptr 1
  .amdhsa_system_sgpr_workgroup_id_x 1
  .amdhsa_float_denorm_mode_32 3
  .amdhsa_float_denorm_mode_16_64 3
.end_amdhsa_kernel
```
